```python
import torch

def _softmax(x, axis=-1):
    return torch.softmax(x, dim=axis)

def _gelu(x):
    return torch.nn.functional.gelu(x, approximate='tanh')

def _silu(x):
    return torch.nn.functional.silu(x)

def _sigmoid(x):
    return torch.sigmoid(x)

def _layernorm(x, axis=-1, eps=1e-05):
    m = x.mean(dim=axis, keepdim=True)
    v = x.var(dim=axis, keepdim=True, unbiased=False)
    return (x - m) / torch.sqrt(v + eps)

def _scatter_add(tgt, idx, src, axis=0):
    return tgt.clone().index_add_(axis, idx, src)

def _segment_sum(src, seg, n):
    out = torch.zeros((n,) + src.shape[1:], dtype=src.dtype)
    return out.index_add_(0, seg, src)

def _pad(x, pw):
    flat = tuple((v for pair in reversed(pw) for v in pair))
    return torch.nn.functional.pad(x, flat)
kernel_name = 'standalone__tree_speculative_verify_tree_attention_over_candidate_token_tree__decode'

def setup_inputs():

    _w = lambda a: (lambda t: t.to(torch.bfloat16) if t.is_floating_point() else t)(torch.as_tensor(a))
    B, Hq, Hkv, T, C, D = (1, 32, 16, 1, 8192, 128)
    tree_mask = torch.zeros((B, T, T), dtype=float)
    for b in range(B):
        parent = torch.zeros(T, dtype=torch.int64)
        for i in range(1, T):
            parent[i] = int(torch.randint(0, i, (1,)).item())
        for i in range(T):
            j = i
            tree_mask[b, i, j] = 1.0
            while j > 0:
                j = parent[j]
                tree_mask[b, i, j] = 1.0
    return {'q': _w((lambda *s: torch.randn(*s, dtype=torch.bfloat16) * 0.8)(B, Hq, T, D)), 'k_cache': _w((lambda *s: torch.randn(*s, dtype=torch.bfloat16) * 0.8)(B, Hkv, C, D)), 'v_cache': _w((lambda *s: torch.randn(*s, dtype=torch.bfloat16) * 0.05)(B, Hkv, C, D)), 'k_tree': _w((lambda *s: torch.randn(*s, dtype=torch.bfloat16) * 0.8)(B, Hkv, T, D)), 'v_tree': _w((lambda *s: torch.randn(*s, dtype=torch.bfloat16) * 0.05)(B, Hkv, T, D)), 'tree_mask': _w(tree_mask)}

def reference(q, k_cache, v_cache, k_tree, v_tree, tree_mask):
    B, Hq, T, D = q.shape
    Hkv, C = (k_cache.shape[1], k_cache.shape[2])
    rep = Hq // Hkv
    kc = (lambda x, n, axis: torch.repeat_interleave(x, n, dim=axis))(k_cache, rep, axis=1)
    vc = (lambda x, n, axis: torch.repeat_interleave(x, n, dim=axis))(v_cache, rep, axis=1)
    kt = (lambda x, n, axis: torch.repeat_interleave(x, n, dim=axis))(k_tree, rep, axis=1)
    vt = (lambda x, n, axis: torch.repeat_interleave(x, n, dim=axis))(v_tree, rep, axis=1)
    k = torch.concatenate([kc, kt], axis=2)
    v = torch.concatenate([vc, vt], axis=2)
    scale = D ** (-0.5)
    scores = torch.einsum('bhqd,bhkd->bhqk', q, k) * scale
    ctx_mask = torch.ones((B, 1, T, C), dtype=scores.dtype)
    tm = tree_mask[:, None, :, :].clone()
    full_mask = torch.concatenate([ctx_mask, tm], axis=-1)
    scores = scores + (1.0 - full_mask) * -1000000000.0
    p = _softmax(scores, axis=-1)
    return torch.einsum('bhqk,bhkd->bhqd', p, v)
```

```asm
; @launch grid=(256,1,1) block=(320,1,1) lds=4240
.amdgcn_target "amdgcn-amd-amdhsa--gfx950"
.text
.globl standalone__tree_speculative_verify_tree_attention_over_candidate_token_tree__decode_kernel
.p2align 8
.type standalone__tree_speculative_verify_tree_attention_over_candidate_token_tree__decode_kernel,@function
standalone__tree_speculative_verify_tree_attention_over_candidate_token_tree__decode_kernel:
    s_load_dwordx8 s[4:11], s[0:1], 0
    s_cmp_ge_u32 s2, 256
    s_cbranch_scc1 L_exit
    v_lshrrev_b32 v4, 6, v0
    v_and_b32 v2, 3, v0
    v_bfe_u32 v5, v0, 4, 2
    v_readfirstlane_b32 s28, v4
    v_lshlrev_b32 v2, 4, v2
    v_lshl_or_b32 v5, v5, 6, v2
    v_bfe_i32 v6, v0, 2, 1
    v_bfe_i32 v7, v0, 3, 1
    s_and_b32 s34, s2, 7
    s_lshr_b32 s35, s2, 3
    s_lshl_b32 s34, s34, 5
    s_or_b32 s36, s34, s35
    s_lshr_b32 s29, s36, 4
    s_lshl_b32 s37, s29, 21
    s_mov_b32 s42, 0x23900
    s_mov_b32 s43, 0x51700
    s_mov_b32 s22, 0x200
    s_mov_b32 s23, 0x1f0c00
    s_mov_b32 s24, 0x90600
    s_mov_b32 s25, 0x80400
    s_mov_b32 s26, 0x150900
    v_and_b32 v6, s42, v6
    v_and_b32 v7, s43, v7
    v_xor_b32 v2, v6, v7
    v_xor_b32 v2, v2, v5
    s_bitcmp1_b32 s36, 0
    s_cselect_b32 s35, 0x121e00, 0
    s_xor_b32 s37, s37, s35
    s_bitcmp1_b32 s36, 1
    s_cselect_b32 s35, 0x151300, 0
    s_xor_b32 s37, s37, s35
    s_bitcmp1_b32 s36, 2
    s_cselect_b32 s35, 0x1a1f00, 0
    s_xor_b32 s37, s37, s35
    s_bitcmp1_b32 s36, 3
    s_cselect_b32 s35, 0x68b00, 0
    s_xor_b32 s37, s37, s35
    s_bitcmp1_b32 s36, 5
    s_cselect_b32 s35, 0x55300, 0
    s_xor_b32 s37, s37, s35
    s_bitcmp1_b32 s36, 6
    s_cselect_b32 s35, 0xa1500, 0
    s_xor_b32 s37, s37, s35
    s_bitcmp1_b32 s36, 7
    s_cselect_b32 s35, 0x111800, 0
    s_xor_b32 s37, s37, s35
    s_bitcmp1_b32 s28, 0
    s_cselect_b32 s35, 0xd1800, 0
    s_xor_b32 s37, s37, s35
    s_bitcmp1_b32 s28, 1
    s_cselect_b32 s35, 0x94600, 0
    s_xor_b32 s37, s37, s35
    v_xor_b32 v24, s37, v2
    v_xor_b32 v25, s22, v24
    v_xor_b32 v26, s23, v25
    v_xor_b32 v27, s22, v26
    v_xor_b32 v28, s24, v27
    v_xor_b32 v29, s22, v28
    v_xor_b32 v30, s23, v29
    v_xor_b32 v2, s22, v30
    s_lshl2_add_u32 s45, s29, s28
    s_lshl_b32 s45, s45, 7
    v_lshlrev_b32 v6, 2, v0
    v_mov_b32 v7, -1
    v_cmp_gt_u32 vcc, 32, v0
    s_mov_b64 exec, vcc
    ds_write_b32 v6, v7 offset:4096
    s_mov_b64 exec, -1
    s_cmp_gt_u32 s28, 0
    s_cbranch_scc0 L_go
    s_barrier
    s_cmp_gt_u32 s28, 1
    s_cbranch_scc0 L_go
    s_barrier
    s_cmp_gt_u32 s28, 2
    s_cbranch_scc0 L_go
    s_barrier
    s_cmp_eq_u32 s28, 4
    s_cbranch_scc1 L_helper
L_go:
    s_cmp_lt_u32 s28, 3
    s_waitcnt lgkmcnt(0)
    s_load_dword s44, s[4:5], s45
    s_load_dword s44, s[4:5], s45 offset:64
    global_load_dwordx4 v[112:115], v24, s[6:7] nt
    global_load_dwordx4 v[116:119], v25, s[6:7] nt
    global_load_dwordx4 v[120:123], v26, s[6:7] nt
    global_load_dwordx4 v[124:127], v27, s[6:7] nt
    global_load_dwordx4 v[128:131], v28, s[6:7] nt
    global_load_dwordx4 v[132:135], v29, s[6:7] nt
    global_load_dwordx4 v[136:139], v30, s[6:7] nt
    s_cbranch_scc0 L_r0
    s_barrier
L_r0:
    global_load_dwordx4 v[140:143], v2, s[6:7] nt
    s_cmp_lt_u32 s28, 2
    s_cbranch_scc0 L_go2
    s_barrier
    s_cmp_lt_u32 s28, 1
    s_cbranch_scc0 L_go2
    s_barrier
L_go2:
    s_load_dwordx8 s[12:19], s[0:1], 32
    s_load_dwordx2 s[20:21], s[0:1], 64
    v_bfe_u32 v6, v0, 3, 1
    v_lshl_or_b32 v7, v6, 8, v5
    s_lshl_b32 s35, s29, 9
    v_or_b32 v7, s35, v7
    v_mov_b64 v[104:105], 0
    v_mov_b64 v[106:107], 0
    v_mov_b64 v[108:109], 0
    v_mov_b64 v[110:111], 0
    s_mov_b32 exec_lo, 0x0f0f0f0f
    s_mov_b32 exec_hi, exec_lo
    global_load_dwordx4 v[104:107], v7, s[4:5]
    s_not_b64 exec, exec
    global_load_dwordx4 v[108:111], v7, s[4:5]
    s_mov_b64 exec, -1
    v_and_b32 v1, 63, v0
    v_lshlrev_b32 v4, 4, v1
    v_bfe_i32 v24, v0, 4, 1
    v_bfe_i32 v25, v0, 5, 1
    v_and_b32 v24, s42, v24
    v_and_b32 v25, s43, v25
    v_and_b32 v3, 0xf0, v4
    v_xor_b32 v24, v24, v25
    v_xor_b32 v3, s37, v3
    v_xor_b32 v3, v3, v24
    v_lshlrev_b32 v7, 5, v6
    s_lshl_b32 s34, s28, 2
    v_add_u32 v6, s34, v7
    s_and_b32 s30, s36, 15
    v_lshlrev_b32 v19, 4, v0
    s_lshl_b32 s41, s29, 19
    s_and_b32 s34, s30, 8
    s_add_u32 s34, s34, s41
    v_lshrrev_b32 v13, 2, v1
    v_lshl_add_u32 v18, v13, 4, s34
    s_mov_b32 s31, 0x3e0293ee
    v_and_b32 v24, 1, v1
    v_lshlrev_b32 v24, 4, v24
    v_mov_b32 v25, 0xffff
    v_lshlrev_b32 v24, v24, v25
    s_mov_b32 vcc_lo, 0x03030303
    s_mov_b32 vcc_hi, vcc_lo
    v_cndmask_b32 v20, 0, v24, vcc
    s_lshl_b64 vcc, vcc, 2
    v_cndmask_b32 v21, 0, v24, vcc
    s_lshl_b64 vcc, vcc, 2
    v_cndmask_b32 v22, 0, v24, vcc
    s_lshl_b64 vcc, vcc, 2
    v_cndmask_b32 v23, 0, v24, vcc
    s_waitcnt vmcnt(2)
    v_xor_b32 v2, s25, v2
    global_load_dwordx4 v[144:147], v2, s[6:7] nt
    v_xor_b32 v2, s22, v2
    global_load_dwordx4 v[148:151], v2, s[6:7] nt
    v_xor_b32 v2, s23, v2
    global_load_dwordx4 v[152:155], v2, s[6:7] nt
    v_xor_b32 v2, s22, v2
    global_load_dwordx4 v[156:159], v2, s[6:7] nt
    v_xor_b32 v2, s24, v2
    global_load_dwordx4 v[160:163], v2, s[6:7] nt
    v_xor_b32 v2, s22, v2
    global_load_dwordx4 v[164:167], v2, s[6:7] nt
    v_xor_b32 v2, s23, v2
    global_load_dwordx4 v[168:171], v2, s[6:7] nt
    v_xor_b32 v2, s22, v2
    global_load_dwordx4 v[172:175], v2, s[6:7] nt
    s_waitcnt vmcnt(0)
    v_xor_b32 v2, s26, v2
    global_load_dwordx4 v[176:179], v2, s[6:7] nt
    v_xor_b32 v2, s22, v2
    global_load_dwordx4 v[180:183], v2, s[6:7] nt
    v_xor_b32 v2, s23, v2
    global_load_dwordx4 v[184:187], v2, s[6:7] nt
    v_xor_b32 v2, s22, v2
    global_load_dwordx4 v[188:191], v2, s[6:7] nt
    v_xor_b32 v2, s24, v2
    global_load_dwordx4 v[192:195], v2, s[6:7] nt
    v_xor_b32 v2, s22, v2
    global_load_dwordx4 v[196:199], v2, s[6:7] nt
    v_xor_b32 v2, s23, v2
    global_load_dwordx4 v[200:203], v2, s[6:7] nt
    v_xor_b32 v2, s22, v2
    global_load_dwordx4 v[204:207], v2, s[6:7] nt
    v_mfma_f32_16x16x32_bf16 v[48:51], v[112:115], v[104:107], 0
    v_mfma_f32_16x16x32_bf16 v[48:51], v[116:119], v[108:111], v[48:51]
    v_mfma_f32_16x16x32_bf16 v[52:55], v[120:123], v[104:107], 0
    v_mfma_f32_16x16x32_bf16 v[52:55], v[124:127], v[108:111], v[52:55]
    v_mfma_f32_16x16x32_bf16 v[56:59], v[128:131], v[104:107], 0
    v_mfma_f32_16x16x32_bf16 v[56:59], v[132:135], v[108:111], v[56:59]
    v_mfma_f32_16x16x32_bf16 v[60:63], v[136:139], v[104:107], 0
    v_mfma_f32_16x16x32_bf16 v[60:63], v[140:143], v[108:111], v[60:63]
    v_mfma_f32_16x16x32_bf16 v[64:67], v[144:147], v[104:107], 0
    v_mfma_f32_16x16x32_bf16 v[64:67], v[148:151], v[108:111], v[64:67]
    v_mfma_f32_16x16x32_bf16 v[68:71], v[152:155], v[104:107], 0
    v_mfma_f32_16x16x32_bf16 v[68:71], v[156:159], v[108:111], v[68:71]
    v_mfma_f32_16x16x32_bf16 v[72:75], v[160:163], v[104:107], 0
    v_mfma_f32_16x16x32_bf16 v[72:75], v[164:167], v[108:111], v[72:75]
    v_mfma_f32_16x16x32_bf16 v[76:79], v[168:171], v[104:107], 0
    v_mfma_f32_16x16x32_bf16 v[76:79], v[172:175], v[108:111], v[76:79]
    v_add_f32_dpp v49, v48, v49 quad_perm:[0,0,0,0] row_mask:0xf bank_mask:0xf
    v_add_f32_dpp v51, v50, v51 quad_perm:[2,2,2,2] row_mask:0xf bank_mask:0xf
    v_add_f32_dpp v53, v52, v53 quad_perm:[0,0,0,0] row_mask:0xf bank_mask:0xf
    v_add_f32_dpp v55, v54, v55 quad_perm:[2,2,2,2] row_mask:0xf bank_mask:0xf
    v_add_f32_dpp v32, v49, v51 quad_perm:[1,1,1,1] row_mask:0xf bank_mask:0xf
    v_add_f32_dpp v33, v53, v55 quad_perm:[1,1,1,1] row_mask:0xf bank_mask:0xf
    v_max_f32 v24, v32, v33
    v_add_f32_dpp v57, v56, v57 quad_perm:[0,0,0,0] row_mask:0xf bank_mask:0xf
    v_add_f32_dpp v59, v58, v59 quad_perm:[2,2,2,2] row_mask:0xf bank_mask:0xf
    v_add_f32_dpp v61, v60, v61 quad_perm:[0,0,0,0] row_mask:0xf bank_mask:0xf
    v_add_f32_dpp v63, v62, v63 quad_perm:[2,2,2,2] row_mask:0xf bank_mask:0xf
    v_add_f32_dpp v34, v57, v59 quad_perm:[1,1,1,1] row_mask:0xf bank_mask:0xf
    v_add_f32_dpp v35, v61, v63 quad_perm:[1,1,1,1] row_mask:0xf bank_mask:0xf
    v_max3_f32 v24, v24, v34, v35
    v_add_f32_dpp v65, v64, v65 quad_perm:[0,0,0,0] row_mask:0xf bank_mask:0xf
    v_add_f32_dpp v67, v66, v67 quad_perm:[2,2,2,2] row_mask:0xf bank_mask:0xf
    v_add_f32_dpp v69, v68, v69 quad_perm:[0,0,0,0] row_mask:0xf bank_mask:0xf
    v_add_f32_dpp v71, v70, v71 quad_perm:[2,2,2,2] row_mask:0xf bank_mask:0xf
    v_add_f32_dpp v36, v65, v67 quad_perm:[1,1,1,1] row_mask:0xf bank_mask:0xf
    v_add_f32_dpp v37, v69, v71 quad_perm:[1,1,1,1] row_mask:0xf bank_mask:0xf
    v_max3_f32 v24, v24, v36, v37
    v_add_f32_dpp v73, v72, v73 quad_perm:[0,0,0,0] row_mask:0xf bank_mask:0xf
    v_add_f32_dpp v75, v74, v75 quad_perm:[2,2,2,2] row_mask:0xf bank_mask:0xf
    v_add_f32_dpp v77, v76, v77 quad_perm:[0,0,0,0] row_mask:0xf bank_mask:0xf
    v_add_f32_dpp v79, v78, v79 quad_perm:[2,2,2,2] row_mask:0xf bank_mask:0xf
    v_add_f32_dpp v38, v73, v75 quad_perm:[1,1,1,1] row_mask:0xf bank_mask:0xf
    v_add_f32_dpp v39, v77, v79 quad_perm:[1,1,1,1] row_mask:0xf bank_mask:0xf
    v_max3_f32 v24, v24, v38, v39
    s_waitcnt vmcnt(0)
    v_xor_b32 v2, s25, v2
    global_load_dwordx4 v[208:211], v2, s[6:7] nt
    v_xor_b32 v2, s22, v2
    global_load_dwordx4 v[212:215], v2, s[6:7] nt
    v_xor_b32 v2, s23, v2
    global_load_dwordx4 v[216:219], v2, s[6:7] nt
    v_xor_b32 v2, s22, v2
    global_load_dwordx4 v[220:223], v2, s[6:7] nt
    v_xor_b32 v2, s24, v2
    global_load_dwordx4 v[224:227], v2, s[6:7] nt
    v_xor_b32 v2, s22, v2
    global_load_dwordx4 v[228:231], v2, s[6:7] nt
    v_xor_b32 v2, s23, v2
    global_load_dwordx4 v[232:235], v2, s[6:7] nt
    v_xor_b32 v2, s22, v2
    global_load_dwordx4 v[236:239], v2, s[6:7] nt
    v_mfma_f32_16x16x32_bf16 v[48:51], v[176:179], v[104:107], 0
    v_mfma_f32_16x16x32_bf16 v[48:51], v[180:183], v[108:111], v[48:51]
    v_mfma_f32_16x16x32_bf16 v[52:55], v[184:187], v[104:107], 0
    v_mfma_f32_16x16x32_bf16 v[52:55], v[188:191], v[108:111], v[52:55]
    v_mfma_f32_16x16x32_bf16 v[56:59], v[192:195], v[104:107], 0
    v_mfma_f32_16x16x32_bf16 v[56:59], v[196:199], v[108:111], v[56:59]
    v_mfma_f32_16x16x32_bf16 v[60:63], v[200:203], v[104:107], 0
    v_mfma_f32_16x16x32_bf16 v[60:63], v[204:207], v[108:111], v[60:63]
    s_waitcnt vmcnt(0)
    global_load_dwordx4 v[112:115], v3, s[8:9] nt
    v_xor_b32 v3, s22, v3
    global_load_dwordx4 v[116:119], v3, s[8:9] nt
    v_xor_b32 v3, s23, v3
    global_load_dwordx4 v[120:123], v3, s[8:9] nt
    v_xor_b32 v3, s22, v3
    global_load_dwordx4 v[124:127], v3, s[8:9] nt
    v_xor_b32 v3, s24, v3
    global_load_dwordx4 v[128:131], v3, s[8:9] nt
    v_xor_b32 v3, s22, v3
    global_load_dwordx4 v[132:135], v3, s[8:9] nt
    v_xor_b32 v3, s23, v3
    global_load_dwordx4 v[136:139], v3, s[8:9] nt
    v_xor_b32 v3, s22, v3
    global_load_dwordx4 v[140:143], v3, s[8:9] nt
    v_xor_b32 v3, s25, v3
    global_load_dwordx4 v[144:147], v3, s[8:9] nt
    v_mfma_f32_16x16x32_bf16 v[64:67], v[208:211], v[104:107], 0
    v_mfma_f32_16x16x32_bf16 v[64:67], v[212:215], v[108:111], v[64:67]
    v_mfma_f32_16x16x32_bf16 v[68:71], v[216:219], v[104:107], 0
    v_mfma_f32_16x16x32_bf16 v[68:71], v[220:223], v[108:111], v[68:71]
    v_mfma_f32_16x16x32_bf16 v[72:75], v[224:227], v[104:107], 0
    v_mfma_f32_16x16x32_bf16 v[72:75], v[228:231], v[108:111], v[72:75]
    v_mfma_f32_16x16x32_bf16 v[76:79], v[232:235], v[104:107], 0
    v_mfma_f32_16x16x32_bf16 v[76:79], v[236:239], v[108:111], v[76:79]
    v_add_f32_dpp v49, v48, v49 quad_perm:[0,0,0,0] row_mask:0xf bank_mask:0xf
    v_add_f32_dpp v51, v50, v51 quad_perm:[2,2,2,2] row_mask:0xf bank_mask:0xf
    v_add_f32_dpp v53, v52, v53 quad_perm:[0,0,0,0] row_mask:0xf bank_mask:0xf
    v_add_f32_dpp v55, v54, v55 quad_perm:[2,2,2,2] row_mask:0xf bank_mask:0xf
    v_add_f32_dpp v40, v49, v51 quad_perm:[1,1,1,1] row_mask:0xf bank_mask:0xf
    v_add_f32_dpp v41, v53, v55 quad_perm:[1,1,1,1] row_mask:0xf bank_mask:0xf
    v_max3_f32 v24, v24, v40, v41
    v_add_f32_dpp v57, v56, v57 quad_perm:[0,0,0,0] row_mask:0xf bank_mask:0xf
    v_add_f32_dpp v59, v58, v59 quad_perm:[2,2,2,2] row_mask:0xf bank_mask:0xf
    v_add_f32_dpp v61, v60, v61 quad_perm:[0,0,0,0] row_mask:0xf bank_mask:0xf
    v_add_f32_dpp v63, v62, v63 quad_perm:[2,2,2,2] row_mask:0xf bank_mask:0xf
    v_add_f32_dpp v42, v57, v59 quad_perm:[1,1,1,1] row_mask:0xf bank_mask:0xf
    v_add_f32_dpp v43, v61, v63 quad_perm:[1,1,1,1] row_mask:0xf bank_mask:0xf
    v_max3_f32 v24, v24, v42, v43
    v_add_f32_dpp v65, v64, v65 quad_perm:[0,0,0,0] row_mask:0xf bank_mask:0xf
    v_add_f32_dpp v67, v66, v67 quad_perm:[2,2,2,2] row_mask:0xf bank_mask:0xf
    v_add_f32_dpp v69, v68, v69 quad_perm:[0,0,0,0] row_mask:0xf bank_mask:0xf
    v_add_f32_dpp v71, v70, v71 quad_perm:[2,2,2,2] row_mask:0xf bank_mask:0xf
    v_add_f32_dpp v44, v65, v67 quad_perm:[1,1,1,1] row_mask:0xf bank_mask:0xf
    v_add_f32_dpp v45, v69, v71 quad_perm:[1,1,1,1] row_mask:0xf bank_mask:0xf
    v_max3_f32 v24, v24, v44, v45
    v_add_f32_dpp v73, v72, v73 quad_perm:[0,0,0,0] row_mask:0xf bank_mask:0xf
    v_add_f32_dpp v75, v74, v75 quad_perm:[2,2,2,2] row_mask:0xf bank_mask:0xf
    v_add_f32_dpp v77, v76, v77 quad_perm:[0,0,0,0] row_mask:0xf bank_mask:0xf
    v_add_f32_dpp v79, v78, v79 quad_perm:[2,2,2,2] row_mask:0xf bank_mask:0xf
    v_add_f32_dpp v46, v73, v75 quad_perm:[1,1,1,1] row_mask:0xf bank_mask:0xf
    v_add_f32_dpp v47, v77, v79 quad_perm:[1,1,1,1] row_mask:0xf bank_mask:0xf
    v_max3_f32 v24, v24, v46, v47
    v_mov_b32 v25, v24
    s_nop 1
    v_permlane32_swap_b32 v24, v25
    v_max_f32 v24, v24, v25
    v_mov_b32 v25, v24
    s_nop 1
    v_permlane16_swap_b32 v24, v25
    v_max_f32 v24, v24, v25
    s_nop 1
    v_mov_b32_dpp v25, v24 quad_perm:[3,3,3,3] row_mask:0xf bank_mask:0xf
    s_nop 1
    v_max_f32_dpp v24, v25, v25 row_half_mirror row_mask:0xf bank_mask:0xf
    v_mul_f32 v24, s31, v24
    v_min_u32 v24, -2, v24
    ds_write_b32 v6, v24 offset:4096
    v_mul_f32 v32, s31, v32
    v_mul_f32 v33, s31, v33
    v_mul_f32 v34, s31, v34
    v_mul_f32 v35, s31, v35
    v_mul_f32 v36, s31, v36
    v_mul_f32 v37, s31, v37
    v_mul_f32 v38, s31, v38
    v_mul_f32 v39, s31, v39
    v_mul_f32 v40, s31, v40
    v_mul_f32 v41, s31, v41
    v_mul_f32 v42, s31, v42
    v_mul_f32 v43, s31, v43
    v_mul_f32 v44, s31, v44
    v_mul_f32 v45, s31, v45
    v_mul_f32 v46, s31, v46
    v_mul_f32 v47, s31, v47
    s_waitcnt vmcnt(1)
    v_xor_b32 v3, s22, v3
    global_load_dwordx4 v[148:151], v3, s[8:9] nt
    v_xor_b32 v3, s23, v3
    global_load_dwordx4 v[152:155], v3, s[8:9] nt
    v_xor_b32 v3, s22, v3
    global_load_dwordx4 v[156:159], v3, s[8:9] nt
    v_xor_b32 v3, s24, v3
    global_load_dwordx4 v[160:163], v3, s[8:9] nt
    v_xor_b32 v3, s22, v3
    global_load_dwordx4 v[164:167], v3, s[8:9] nt
    v_xor_b32 v3, s23, v3
    global_load_dwordx4 v[168:171], v3, s[8:9] nt
    v_xor_b32 v3, s22, v3
    global_load_dwordx4 v[172:175], v3, s[8:9] nt
L_ms:
    ds_read_b128 v[28:31], v7 offset:4096
    ds_read_b32 v27, v7 offset:4112
    s_waitcnt lgkmcnt(0)
    v_max3_u32 v24, v28, v29, v30
    v_max3_u32 v24, v24, v31, v27
    v_cmp_eq_u32 vcc, -1, v24
    s_cbranch_vccnz L_ms
    v_max3_f32 v24, v28, v29, v30
    v_max3_f32 v24, v24, v31, v27
    v_sub_f32 v32, v32, v24
    v_sub_f32 v33, v33, v24
    v_sub_f32 v34, v34, v24
    v_sub_f32 v35, v35, v24
    v_sub_f32 v36, v36, v24
    v_sub_f32 v37, v37, v24
    v_sub_f32 v38, v38, v24
    v_sub_f32 v39, v39, v24
    v_sub_f32 v40, v40, v24
    v_sub_f32 v41, v41, v24
    v_sub_f32 v42, v42, v24
    v_sub_f32 v43, v43, v24
    v_sub_f32 v44, v44, v24
    v_sub_f32 v45, v45, v24
    v_sub_f32 v46, v46, v24
    v_sub_f32 v47, v47, v24
    v_exp_f32_dpp v32, v32 quad_perm:[3,3,3,3] row_mask:0xf bank_mask:0xf
    v_exp_f32_dpp v33, v33 quad_perm:[3,3,3,3] row_mask:0xf bank_mask:0xf
    v_exp_f32_dpp v34, v34 quad_perm:[3,3,3,3] row_mask:0xf bank_mask:0xf
    v_exp_f32_dpp v35, v35 quad_perm:[3,3,3,3] row_mask:0xf bank_mask:0xf
    v_exp_f32_dpp v36, v36 quad_perm:[3,3,3,3] row_mask:0xf bank_mask:0xf
    v_exp_f32_dpp v37, v37 quad_perm:[3,3,3,3] row_mask:0xf bank_mask:0xf
    v_exp_f32_dpp v38, v38 quad_perm:[3,3,3,3] row_mask:0xf bank_mask:0xf
    v_exp_f32_dpp v39, v39 quad_perm:[3,3,3,3] row_mask:0xf bank_mask:0xf
    v_exp_f32_dpp v40, v40 quad_perm:[3,3,3,3] row_mask:0xf bank_mask:0xf
    v_exp_f32_dpp v41, v41 quad_perm:[3,3,3,3] row_mask:0xf bank_mask:0xf
    v_exp_f32_dpp v42, v42 quad_perm:[3,3,3,3] row_mask:0xf bank_mask:0xf
    v_exp_f32_dpp v43, v43 quad_perm:[3,3,3,3] row_mask:0xf bank_mask:0xf
    v_exp_f32_dpp v44, v44 quad_perm:[3,3,3,3] row_mask:0xf bank_mask:0xf
    v_exp_f32_dpp v45, v45 quad_perm:[3,3,3,3] row_mask:0xf bank_mask:0xf
    v_exp_f32_dpp v46, v46 quad_perm:[3,3,3,3] row_mask:0xf bank_mask:0xf
    v_exp_f32_dpp v47, v47 quad_perm:[3,3,3,3] row_mask:0xf bank_mask:0xf
    v_add_f32 v25, v32, v33
    v_add_f32 v25, v25, v34
    v_add_f32 v25, v25, v35
    v_add_f32 v25, v25, v36
    v_add_f32 v25, v25, v37
    v_add_f32 v25, v25, v38
    v_add_f32 v25, v25, v39
    v_add_f32 v25, v25, v40
    v_add_f32 v25, v25, v41
    v_add_f32 v25, v25, v42
    v_add_f32 v25, v25, v43
    v_add_f32 v25, v25, v44
    v_add_f32 v25, v25, v45
    v_add_f32 v25, v25, v46
    v_add_f32 v25, v25, v47
    v_mov_b32 v26, v25
    v_cvt_pk_bf16_f32 v32, v32, v32
    v_cvt_pk_bf16_f32 v33, v33, v33
    v_permlane32_swap_b32 v25, v26
    v_add_f32 v25, v25, v26
    v_mov_b32 v26, v25
    v_cvt_pk_bf16_f32 v34, v34, v34
    v_cvt_pk_bf16_f32 v35, v35, v35
    v_permlane16_swap_b32 v25, v26
    v_add_f32 v26, v25, v26
    v_cvt_pk_bf16_f32 v36, v36, v36
    v_cvt_pk_bf16_f32 v37, v37, v37
    v_add_f32_dpp v25, v26, v26 row_half_mirror row_mask:0xf bank_mask:0xf
    v_and_b32 v25, 0x7fffffff, v25
    ds_write_b32 v6, v25 offset:4160
    v_cvt_pk_bf16_f32 v38, v38, v38
    v_cvt_pk_bf16_f32 v39, v39, v39
    v_cvt_pk_bf16_f32 v40, v40, v40
    v_cvt_pk_bf16_f32 v41, v41, v41
    v_cvt_pk_bf16_f32 v42, v42, v42
    v_cvt_pk_bf16_f32 v43, v43, v43
    v_cvt_pk_bf16_f32 v44, v44, v44
    v_cvt_pk_bf16_f32 v45, v45, v45
    v_cvt_pk_bf16_f32 v46, v46, v46
    v_cvt_pk_bf16_f32 v47, v47, v47
    v_mov_b32_dpp v26, v32 row_half_mirror row_mask:0xf bank_mask:0xf
    v_and_b32 v48, v32, v20
    v_and_b32 v49, v32, v21
    v_and_b32 v50, v26, v22
    v_and_b32 v51, v26, v23
    v_and_b32 v52, v26, v20
    v_and_b32 v53, v26, v21
    v_and_b32 v54, v32, v22
    v_and_b32 v55, v32, v23
    v_mov_b32_dpp v26, v33 row_half_mirror row_mask:0xf bank_mask:0xf
    v_and_b32 v56, v33, v20
    v_and_b32 v57, v33, v21
    v_and_b32 v58, v26, v22
    v_and_b32 v59, v26, v23
    v_and_b32 v60, v26, v20
    v_and_b32 v61, v26, v21
    v_and_b32 v62, v33, v22
    v_and_b32 v63, v33, v23
    v_mov_b32_dpp v26, v34 row_half_mirror row_mask:0xf bank_mask:0xf
    v_and_b32 v64, v34, v20
    v_and_b32 v65, v34, v21
    v_and_b32 v66, v26, v22
    v_and_b32 v67, v26, v23
    v_and_b32 v68, v26, v20
    v_and_b32 v69, v26, v21
    v_and_b32 v70, v34, v22
    v_and_b32 v71, v34, v23
    v_mov_b32_dpp v26, v35 row_half_mirror row_mask:0xf bank_mask:0xf
    v_and_b32 v72, v35, v20
    v_and_b32 v73, v35, v21
    v_and_b32 v74, v26, v22
    v_and_b32 v75, v26, v23
    v_and_b32 v76, v26, v20
    v_and_b32 v77, v26, v21
    v_and_b32 v78, v35, v22
    v_and_b32 v79, v35, v23
    v_mov_b32_dpp v26, v36 row_half_mirror row_mask:0xf bank_mask:0xf
    v_and_b32 v80, v36, v20
    v_and_b32 v81, v36, v21
    v_and_b32 v82, v26, v22
    v_and_b32 v83, v26, v23
    v_and_b32 v84, v26, v20
    v_and_b32 v85, v26, v21
    v_and_b32 v86, v36, v22
    v_and_b32 v87, v36, v23
    v_mov_b32_dpp v26, v37 row_half_mirror row_mask:0xf bank_mask:0xf
    v_and_b32 v88, v37, v20
    v_and_b32 v89, v37, v21
    v_and_b32 v90, v26, v22
    v_and_b32 v91, v26, v23
    v_and_b32 v92, v26, v20
    v_and_b32 v93, v26, v21
    v_and_b32 v94, v37, v22
    v_and_b32 v95, v37, v23
    v_mov_b32_dpp v26, v38 row_half_mirror row_mask:0xf bank_mask:0xf
    v_and_b32 v96, v38, v20
    v_and_b32 v97, v38, v21
    v_and_b32 v98, v26, v22
    v_and_b32 v99, v26, v23
    v_and_b32 v100, v26, v20
    v_and_b32 v101, v26, v21
    v_and_b32 v102, v38, v22
    v_and_b32 v103, v38, v23
    v_mov_b32_dpp v26, v39 row_half_mirror row_mask:0xf bank_mask:0xf
    v_and_b32 v104, v39, v20
    v_and_b32 v105, v39, v21
    v_and_b32 v106, v26, v22
    v_and_b32 v107, v26, v23
    v_and_b32 v108, v26, v20
    v_and_b32 v109, v26, v21
    v_and_b32 v110, v39, v22
    v_and_b32 v111, v39, v23
    v_mfma_f32_16x16x32_bf16 v[8:11], v[48:51], v[112:115], 0
    v_mfma_f32_16x16x32_bf16 v[8:11], v[52:55], v[116:119], v[8:11]
    v_mfma_f32_16x16x32_bf16 v[8:11], v[56:59], v[120:123], v[8:11]
    v_mfma_f32_16x16x32_bf16 v[8:11], v[60:63], v[124:127], v[8:11]
    v_mfma_f32_16x16x32_bf16 v[8:11], v[64:67], v[128:131], v[8:11]
    v_mfma_f32_16x16x32_bf16 v[8:11], v[68:71], v[132:135], v[8:11]
    v_mfma_f32_16x16x32_bf16 v[8:11], v[72:75], v[136:139], v[8:11]
    v_mfma_f32_16x16x32_bf16 v[8:11], v[76:79], v[140:143], v[8:11]
    s_waitcnt vmcnt(0)
    v_xor_b32 v3, s26, v3
    global_load_dwordx4 v[176:179], v3, s[8:9] nt
    v_xor_b32 v3, s22, v3
    global_load_dwordx4 v[180:183], v3, s[8:9] nt
    v_xor_b32 v3, s23, v3
    global_load_dwordx4 v[184:187], v3, s[8:9] nt
    v_xor_b32 v3, s22, v3
    global_load_dwordx4 v[188:191], v3, s[8:9] nt
    v_xor_b32 v3, s24, v3
    global_load_dwordx4 v[192:195], v3, s[8:9] nt
    v_xor_b32 v3, s22, v3
    global_load_dwordx4 v[196:199], v3, s[8:9] nt
    v_xor_b32 v3, s23, v3
    global_load_dwordx4 v[200:203], v3, s[8:9] nt
    v_xor_b32 v3, s22, v3
    global_load_dwordx4 v[204:207], v3, s[8:9] nt
    v_mov_b32 v15, 0
    ds_read_b32 v15, v15 offset:4224
    v_mfma_f32_16x16x32_bf16 v[8:11], v[80:83], v[144:147], v[8:11]
    v_mfma_f32_16x16x32_bf16 v[8:11], v[84:87], v[148:151], v[8:11]
    v_mfma_f32_16x16x32_bf16 v[8:11], v[88:91], v[152:155], v[8:11]
    v_mfma_f32_16x16x32_bf16 v[8:11], v[92:95], v[156:159], v[8:11]
    v_mfma_f32_16x16x32_bf16 v[8:11], v[96:99], v[160:163], v[8:11]
    v_mfma_f32_16x16x32_bf16 v[8:11], v[100:103], v[164:167], v[8:11]
    v_mfma_f32_16x16x32_bf16 v[8:11], v[104:107], v[168:171], v[8:11]
    v_mfma_f32_16x16x32_bf16 v[8:11], v[108:111], v[172:175], v[8:11]
    v_mov_b32_dpp v26, v40 row_half_mirror row_mask:0xf bank_mask:0xf
    v_and_b32 v48, v40, v20
    v_and_b32 v49, v40, v21
    v_and_b32 v50, v26, v22
    v_and_b32 v51, v26, v23
    v_and_b32 v52, v26, v20
    v_and_b32 v53, v26, v21
    v_and_b32 v54, v40, v22
    v_and_b32 v55, v40, v23
    v_mov_b32_dpp v26, v41 row_half_mirror row_mask:0xf bank_mask:0xf
    v_and_b32 v56, v41, v20
    v_and_b32 v57, v41, v21
    v_and_b32 v58, v26, v22
    v_and_b32 v59, v26, v23
    v_and_b32 v60, v26, v20
    v_and_b32 v61, v26, v21
    v_and_b32 v62, v41, v22
    v_and_b32 v63, v41, v23
    v_mov_b32_dpp v26, v42 row_half_mirror row_mask:0xf bank_mask:0xf
    v_and_b32 v64, v42, v20
    v_and_b32 v65, v42, v21
    v_and_b32 v66, v26, v22
    v_and_b32 v67, v26, v23
    v_and_b32 v68, v26, v20
    v_and_b32 v69, v26, v21
    v_and_b32 v70, v42, v22
    v_and_b32 v71, v42, v23
    v_mov_b32_dpp v26, v43 row_half_mirror row_mask:0xf bank_mask:0xf
    v_and_b32 v72, v43, v20
    v_and_b32 v73, v43, v21
    v_and_b32 v74, v26, v22
    v_and_b32 v75, v26, v23
    v_and_b32 v76, v26, v20
    v_and_b32 v77, v26, v21
    v_and_b32 v78, v43, v22
    v_and_b32 v79, v43, v23
    v_mov_b32_dpp v26, v44 row_half_mirror row_mask:0xf bank_mask:0xf
    v_and_b32 v80, v44, v20
    v_and_b32 v81, v44, v21
    v_and_b32 v82, v26, v22
    v_and_b32 v83, v26, v23
    v_and_b32 v84, v26, v20
    v_and_b32 v85, v26, v21
    v_and_b32 v86, v44, v22
    v_and_b32 v87, v44, v23
    v_mov_b32_dpp v26, v45 row_half_mirror row_mask:0xf bank_mask:0xf
    v_and_b32 v88, v45, v20
    v_and_b32 v89, v45, v21
    v_and_b32 v90, v26, v22
    v_and_b32 v91, v26, v23
    v_and_b32 v92, v26, v20
    v_and_b32 v93, v26, v21
    v_and_b32 v94, v45, v22
    v_and_b32 v95, v45, v23
    v_mov_b32_dpp v26, v46 row_half_mirror row_mask:0xf bank_mask:0xf
    v_and_b32 v96, v46, v20
    v_and_b32 v97, v46, v21
    v_and_b32 v98, v26, v22
    v_and_b32 v99, v26, v23
    v_and_b32 v100, v26, v20
    v_and_b32 v101, v26, v21
    v_and_b32 v102, v46, v22
    v_and_b32 v103, v46, v23
    v_mov_b32_dpp v26, v47 row_half_mirror row_mask:0xf bank_mask:0xf
    v_and_b32 v104, v47, v20
    v_and_b32 v105, v47, v21
    v_and_b32 v106, v26, v22
    v_and_b32 v107, v26, v23
    v_and_b32 v108, v26, v20
    v_and_b32 v109, v26, v21
    v_and_b32 v110, v47, v22
    v_and_b32 v111, v47, v23
    s_lshl_b32 s34, s36, 15
    v_add_u32 v26, s34, v4
    s_waitcnt lgkmcnt(0)
    v_readfirstlane_b32 s33, v15
    s_cmp_lg_u32 s28, 0
    s_waitcnt vmcnt(7)
    v_xor_b32 v3, s25, v3
    global_load_dwordx4 v[208:211], v3, s[8:9] nt
    s_waitcnt vmcnt(7)
    v_xor_b32 v3, s22, v3
    global_load_dwordx4 v[212:215], v3, s[8:9] nt
    s_waitcnt vmcnt(7)
    v_xor_b32 v3, s23, v3
    global_load_dwordx4 v[216:219], v3, s[8:9] nt
    s_waitcnt vmcnt(7)
    v_xor_b32 v3, s22, v3
    global_load_dwordx4 v[220:223], v3, s[8:9] nt
    s_waitcnt vmcnt(7)
    v_xor_b32 v3, s24, v3
    global_load_dwordx4 v[224:227], v3, s[8:9] nt
    s_waitcnt vmcnt(7)
    v_xor_b32 v3, s22, v3
    global_load_dwordx4 v[228:231], v3, s[8:9] nt
    s_waitcnt vmcnt(7)
    v_xor_b32 v3, s23, v3
    global_load_dwordx4 v[232:235], v3, s[8:9] nt
    s_waitcnt vmcnt(7)
    v_xor_b32 v3, s22, v3
    global_load_dwordx4 v[236:239], v3, s[8:9] nt
    s_cbranch_scc1 L_nh
    global_load_dwordx2 v[16:17], v18, s[20:21] offset:1024 sc1
L_nh:
    s_cselect_b32 s34, 0, s33
    v_mfma_f32_16x16x32_bf16 v[8:11], v[48:51], v[176:179], v[8:11]
    v_mfma_f32_16x16x32_bf16 v[8:11], v[52:55], v[180:183], v[8:11]
    v_mfma_f32_16x16x32_bf16 v[8:11], v[56:59], v[184:187], v[8:11]
    v_mfma_f32_16x16x32_bf16 v[8:11], v[60:63], v[188:191], v[8:11]
    v_mfma_f32_16x16x32_bf16 v[8:11], v[64:67], v[192:195], v[8:11]
    v_mfma_f32_16x16x32_bf16 v[8:11], v[68:71], v[196:199], v[8:11]
    v_mfma_f32_16x16x32_bf16 v[8:11], v[72:75], v[200:203], v[8:11]
    v_mfma_f32_16x16x32_bf16 v[8:11], v[76:79], v[204:207], v[8:11]
    s_cmp_eq_u32 s28, 3
    s_cbranch_scc1 L_fin
    s_cmp_lg_u32 s34, 0
    s_waitcnt vmcnt(7)
    v_mfma_f32_16x16x32_bf16 v[8:11], v[80:83], v[208:211], v[8:11]
    s_waitcnt vmcnt(6)
    v_mfma_f32_16x16x32_bf16 v[8:11], v[84:87], v[212:215], v[8:11]
    s_waitcnt vmcnt(5)
    v_mfma_f32_16x16x32_bf16 v[8:11], v[88:91], v[216:219], v[8:11]
    s_waitcnt vmcnt(4)
    v_mfma_f32_16x16x32_bf16 v[8:11], v[92:95], v[220:223], v[8:11]
    s_waitcnt vmcnt(3)
    v_mfma_f32_16x16x32_bf16 v[8:11], v[96:99], v[224:227], v[8:11]
    s_waitcnt vmcnt(2)
    v_mfma_f32_16x16x32_bf16 v[8:11], v[100:103], v[228:231], v[8:11]
    s_waitcnt vmcnt(1)
    v_mfma_f32_16x16x32_bf16 v[8:11], v[104:107], v[232:235], v[8:11]
    s_waitcnt vmcnt(0)
    v_mfma_f32_16x16x32_bf16 v[8:11], v[108:111], v[236:239], v[8:11]
    s_nop 7
    ds_write_b128 v19, v[8:11]
    s_cbranch_scc1 L_poll
    s_waitcnt lgkmcnt(0)
    s_barrier
L_exit:
    s_endpgm
L_helper:
    s_load_dwordx8 s[12:19], s[0:1], 32
    s_load_dwordx2 s[20:21], s[0:1], 64
    v_and_b32 v1, 63, v0
    s_and_b32 s30, s36, 15
    v_lshlrev_b32 v4, 4, v1
    v_lshrrev_b32 v10, 5, v1
    s_getreg_b32 s32, hwreg(HW_REG_XCC_ID, 0, 4)
    s_add_u32 s32, s32, 1
    s_lshl_b32 s46, s29, 4
    v_mov_b32 v18, s46
    v_mov_b64 v[44:45], -1
    v_mov_b64 v[46:47], -1
    v_mov_b64 v[24:25], 0
    v_mov_b64 v[26:27], 0
    v_mov_b32 v20, 0xff7fffff
    v_mov_b32 v19, s32
    s_lshl_b32 s41, s29, 19
    s_lshl_b32 s35, s29, 8
    s_cmp_lg_u32 s30, 0
    s_waitcnt lgkmcnt(0)
    s_cbranch_scc1 L_np
    v_lshl_add_u32 v11, v1, 2, s41
    global_store_dword v11, v44, s[20:21] offset:1024
    s_waitcnt vmcnt(0)
    s_mov_b64 exec, 1
    global_store_dword v18, v19, s[18:19] sc1
    s_mov_b64 exec, -1
    s_load_dword s44, s[20:21], s41 offset:1024
    s_load_dword s44, s[20:21], s41 offset:1088
    s_load_dword s44, s[20:21], s41 offset:1152
    s_load_dword s44, s[20:21], s41 offset:1216
L_np:
    s_cmp_lg_u32 s30, 1
    s_cbranch_scc1 L_nt
    s_load_dword s44, s[10:11], s35 offset:0
    s_load_dword s44, s[10:11], s35 offset:64
    s_load_dword s44, s[10:11], s35 offset:128
    s_load_dword s44, s[10:11], s35 offset:192
    s_load_dword s44, s[12:13], s35 offset:0
    s_load_dword s44, s[12:13], s35 offset:64
    s_load_dword s44, s[12:13], s35 offset:128
    s_load_dword s44, s[12:13], s35 offset:192
    s_load_dword s47, s[14:15], 0
    v_or_b32 v11, s35, v5
    v_bfe_u32 v12, v1, 3, 1
    v_lshl_add_u32 v13, v12, 8, v11
    v_add_u32 v13, s35, v13
    v_and_b32 v14, 15, v1
    v_bfe_u32 v12, v1, 4, 1
    v_lshl_add_u32 v14, v14, 1, v12
    v_lshl_add_u32 v14, v14, 3, s35
    s_mov_b32 s31, 0x3e0293ee
    s_waitcnt lgkmcnt(0)
    global_load_dwordx4 v[36:39], v11, s[10:11]
    global_load_dwordx4 v[40:43], v13, s[4:5]
    global_load_dwordx2 v[28:29], v14, s[12:13]
    s_waitcnt vmcnt(0)
    v_mfma_f32_16x16x32_bf16 v[32:35], v[36:39], v[40:43], 0
    s_lshl_b32 s47, s47, 16
    v_sub_f32 v11, 1.0, s47
    v_mul_f32 v11, 0xceabfb8f, v11
    v_lshlrev_b32 v24, 16, v28
    v_and_b32 v25, 0xffff0000, v28
    v_lshlrev_b32 v26, 16, v29
    v_and_b32 v27, 0xffff0000, v29
    v_cmp_gt_u32 vcc, 32, v1
    v_add_f32_dpp v33, v32, v33 quad_perm:[0,0,0,0] row_mask:0xf bank_mask:0xf
    v_add_f32_dpp v35, v34, v35 quad_perm:[2,2,2,2] row_mask:0xf bank_mask:0xf
    s_nop 0
    v_add_f32_dpp v32, v33, v35 quad_perm:[1,1,1,1] row_mask:0xf bank_mask:0xf
    v_fma_f32 v32, v32, s31, v11
    s_nop 1
    v_mov_b32_dpp v33, v32 row_newbcast:3 row_mask:0xf bank_mask:0xf
    v_mov_b32_dpp v34, v32 row_newbcast:11 row_mask:0xf bank_mask:0xf
    v_cndmask_b32 v20, v34, v33, vcc
L_nt:
    v_lshlrev_b32 v6, 5, v10
    v_min_u32 v20, -2, v20
    s_mov_b32 s35, 3
    s_lshl_b32 s34, s30, 6
    s_or_b32 s34, s34, s41
    v_lshrrev_b32 v8, 2, v1
    v_lshl_or_b32 v9, v8, 15, s34
    v_and_b32 v11, 48, v4
    v_or_b32 v11, v11, v9
    s_lshl_b32 s34, s30, 4
    s_add_u32 s34, s34, s41
    v_lshl_add_u32 v21, v10, 3, s34
L_m0:
    ds_read_b32 v12, v6 offset:4096
    s_waitcnt lgkmcnt(0)
    v_cmp_eq_u32 vcc, -1, v12
    s_cbranch_vccnz L_m0
    s_load_dword s47, s[18:19], s46
L_fl:
    s_waitcnt lgkmcnt(0)
    s_cmp_lg_u32 s47, 0
    s_cbranch_scc1 L_fl2
    s_sub_u32 s35, s35, 1
    s_cbranch_scc1 L_fl2
    s_load_dword s47, s[18:19], s46 glc
    s_branch L_fl
L_fl2:
    s_cmp_eq_u32 s47, s32
    s_cselect_b32 s33, 1, 0
    s_cmp_eq_u32 s30, 0
    s_cselect_b32 s33, 1, s33
    v_mov_b32 v22, s33
    v_mov_b32 v23, 0
    ds_write_b32 v23, v22 offset:4224
    ds_write_b32 v6, v20 offset:4112
    s_cmp_eq_u32 s33, 0
    s_cbranch_scc1 L_nomk
    global_store_dwordx4 v11, v[44:47], s[20:21]
L_nomk:
    ds_read_b128 v[12:15], v6 offset:4096
    s_waitcnt lgkmcnt(0)
    v_max3_u32 v22, v12, v13, v14
    v_max_u32 v22, v22, v15
    v_cmp_eq_u32 vcc, -1, v22
    s_cbranch_vccnz L_nomk
    v_max3_f32 v16, v12, v13, v14
    v_max3_f32 v16, v16, v15, v20
    v_sub_f32 v20, v20, v16
    v_exp_f32 v20, v20
    s_nop 0
    v_mul_f32 v24, v20, v24
    v_mul_f32 v25, v20, v25
    v_mul_f32 v26, v20, v26
    v_mul_f32 v27, v20, v27
    ds_write_b128 v4, v[24:27] offset:3072
L_ls:
    ds_read_b128 v[12:15], v6 offset:4160
    s_waitcnt lgkmcnt(0)
    v_max3_u32 v22, v12, v13, v14
    v_max_u32 v22, v22, v15
    v_cmp_eq_u32 vcc, -1, v22
    s_cbranch_vccnz L_ls
    v_add_f32 v12, v12, v13
    v_add_f32 v14, v14, v15
    v_add_f32 v12, v12, v14
    v_add_f32 v17, v12, v20
    s_waitcnt vmcnt(0)
    s_cbranch_scc1 L_hs
    global_store_dwordx2 v21, v[16:17], s[20:21] offset:1024
    s_endpgm
L_hs:
    global_store_dwordx2 v21, v[16:17], s[20:21] offset:3072 sc1
    s_waitcnt vmcnt(0)
    s_endpgm
L_poll:
    s_mov_b32 s40, 0
    s_cmp_eq_u32 s30, 0
    s_cselect_b32 s38, 0, -1
    s_mov_b32 s39, 0x400000
L_hc:
    v_max_u32 v28, v16, v17
    v_cmp_eq_u32 vcc, -1, v28
    s_cbranch_vccnz L_hr
L_hok:
    global_load_dwordx4 v[48:51], v26, s[20:21] nt
    v_and_b32 v27, 3, v1
    v_lshrrev_b32 v24, 4, v1
    v_lshl_add_u32 v24, v27, 3, v24
    s_lshl_b32 s34, s30, 6
    s_and_b32 s34, s34, 0xc0
    s_mul_i32 s35, s30, 34
    s_and_b32 s35, s35, 0x108
    s_or_b32 s34, s34, s35
    s_lshl_b32 s35, s29, 9
    s_or_b32 s34, s34, s35
    v_lshl_add_u32 v27, v24, 1, s34
    v_max_f32_dpp v28, v16, v16 row_ror:8 row_mask:0xf bank_mask:0xf
    s_nop 1
    v_max_f32_dpp v28, v28, v28 row_ror:4 row_mask:0xf bank_mask:0xf
    v_mov_b32 v29, v28
    s_nop 1
    v_permlane16_swap_b32 v28, v29
    v_max_f32 v28, v28, v29
    v_mov_b32 v29, v28
    s_nop 1
    v_permlane32_swap_b32 v28, v29
    v_max_f32 v28, v28, v29
    v_sub_f32 v16, v16, v28
    v_exp_f32 v16, v16
    s_nop 0
    v_mul_f32 v17, v16, v17
    s_nop 1
    v_add_f32_dpp v28, v17, v17 row_ror:8 row_mask:0xf bank_mask:0xf
    s_nop 1
    v_add_f32_dpp v28, v28, v28 row_ror:4 row_mask:0xf bank_mask:0xf
    v_mov_b32 v29, v28
    s_nop 1
    v_permlane16_swap_b32 v28, v29
    v_add_f32 v28, v28, v29
    v_mov_b32 v29, v28
    s_nop 1
    v_permlane32_swap_b32 v28, v29
    v_add_f32 v28, v28, v29
    v_rcp_f32 v28, v28
    s_cmp_eq_u32 s33, 0
    v_mul_f32 v16, v16, v28
    s_cbranch_scc1 L_b0
    s_mov_b32 s33, 0
    s_waitcnt lgkmcnt(0)
    s_barrier
L_b0:
    s_waitcnt vmcnt(0)
L_bp:
    global_load_dwordx4 v[48:51], v26, s[20:21] nt
    s_sub_u32 s39, s39, 1
    s_cbranch_scc1 L_bok
    s_waitcnt vmcnt(3)
    v_max3_u32 v31, v48, v49, v50
    v_max_u32 v31, v31, v51
    v_cmp_eq_u32 vcc, -1, v31
    v_mul_f32 v8, v16, v48
    v_mul_f32 v10, v16, v50
    v_mul_f32 v9, v16, v49
    v_mul_f32 v11, v16, v51
    s_cbranch_vccnz L_bp
L_bok:
    v_permlane32_swap_b32 v8, v10
    v_permlane32_swap_b32 v9, v11
    v_add_f32 v8, v8, v10
    v_add_f32 v9, v9, v11
    s_cmp_eq_u32 s40, 0
    s_nop 0
    v_permlane16_swap_b32 v8, v9
    v_add_f32 v8, v8, v9
    s_nop 1
    v_add_f32_dpp v8, v8, v8 row_ror:8 row_mask:0xf bank_mask:0xf
    s_nop 1
    v_add_f32_dpp v8, v8, v8 row_ror:4 row_mask:0xf bank_mask:0xf
    v_cvt_pk_bf16_f32 v8, v8, v8
    global_store_short v27, v8, s[16:17]
    s_cbranch_scc0 L_more
    s_endpgm
L_fin:
    s_lshl_b32 s34, s30, 6
    s_or_b32 s34, s34, s41
    v_lshl_or_b32 v12, v13, 15, s34
    v_and_b32 v5, 48, v4
    v_or_b32 v5, v5, v12
    s_cmp_eq_u32 s33, 0
    s_waitcnt vmcnt(7)
    v_mfma_f32_16x16x32_bf16 v[8:11], v[80:83], v[208:211], v[8:11]
    s_waitcnt vmcnt(6)
    v_mfma_f32_16x16x32_bf16 v[8:11], v[84:87], v[212:215], v[8:11]
    s_waitcnt vmcnt(5)
    v_mfma_f32_16x16x32_bf16 v[8:11], v[88:91], v[216:219], v[8:11]
    s_barrier
    ds_read_b128 v[32:35], v4 offset:0
    ds_read_b128 v[36:39], v4 offset:1024
    ds_read_b128 v[40:43], v4 offset:2048
    ds_read_b128 v[44:47], v4 offset:3072
    s_waitcnt vmcnt(4)
    v_mfma_f32_16x16x32_bf16 v[8:11], v[92:95], v[220:223], v[8:11]
    s_waitcnt vmcnt(3)
    v_mfma_f32_16x16x32_bf16 v[8:11], v[96:99], v[224:227], v[8:11]
    s_waitcnt vmcnt(2)
    v_mfma_f32_16x16x32_bf16 v[8:11], v[100:103], v[228:231], v[8:11]
    s_waitcnt lgkmcnt(2)
    v_pk_add_f32 v[32:33], v[32:33], v[36:37]
    v_pk_add_f32 v[34:35], v[34:35], v[38:39]
    s_waitcnt lgkmcnt(0)
    v_pk_add_f32 v[40:41], v[40:41], v[44:45]
    v_pk_add_f32 v[42:43], v[42:43], v[46:47]
    s_waitcnt vmcnt(1)
    v_mfma_f32_16x16x32_bf16 v[8:11], v[104:107], v[232:235], v[8:11]
    v_pk_add_f32 v[32:33], v[32:33], v[40:41]
    v_pk_add_f32 v[34:35], v[34:35], v[42:43]
    s_waitcnt vmcnt(0)
    v_mfma_f32_16x16x32_bf16 v[8:11], v[108:111], v[236:239], v[8:11]
    s_cbranch_scc1 L_bs
    s_nop 6
    v_pk_add_f32 v[8:9], v[8:9], v[32:33]
    v_pk_add_f32 v[10:11], v[10:11], v[34:35]
    global_store_dwordx4 v5, v[8:11], s[20:21]
    s_endpgm
L_bs:
    s_lshl_b32 s34, 1, s30
    s_lshl_b32 s35, s29, 4
    v_mov_b32 v2, s34
    v_mov_b32 v3, s35
    s_nop 2
    v_pk_add_f32 v[8:9], v[8:9], v[32:33]
    v_pk_add_f32 v[10:11], v[10:11], v[34:35]
    global_store_dwordx4 v5, v[8:11], s[20:21] offset:2048 sc1
    s_waitcnt vmcnt(0)
    s_mov_b64 exec, 1
    global_atomic_or v3, v2, s[18:19] offset:4 sc1
    s_endpgm
L_more:
    s_max_i32 s39, s39, 64
    s_ff1_i32_b32 s30, s40
    s_bitset0_b32 s40, s30
    s_and_b32 s34, s30, 8
    v_and_b32 v18, -9, v18
    v_or_b32 v18, s34, v18
    global_load_dwordx2 v[16:17], v18, s[20:21] offset:1024 sc1
    s_lshl_b32 s34, s30, 15
    s_or_b32 s34, s34, s41
    v_add_u32 v26, s34, v4
    s_waitcnt vmcnt(0)
    s_branch L_hc
L_hr:
    s_cmp_eq_u32 s33, 0
    s_cbranch_scc1 L_hr2
    s_mov_b32 s33, 0
    global_load_dword v25, v26, s[20:21] sc1
    s_waitcnt lgkmcnt(0)
    s_barrier
L_hr2:
    s_sub_u32 s39, s39, 1
    s_cbranch_scc1 L_hto
    s_cmp_eq_u32 s38, -1
    s_cbranch_scc1 L_hl
    s_lshl_b32 s34, s29, 4
    v_mov_b32 v28, s34
    global_load_dword v28, v28, s[18:19] offset:4 sc1
    s_waitcnt vmcnt(0)
    v_readfirstlane_b32 s34, v28
    s_nop 0
    s_andn2_b32 s34, s34, s38
    s_cbranch_scc0 L_hl
    s_ff1_i32_b32 s34, s34
    s_bitset1_b32 s38, s34
    s_bitset1_b32 s40, s34
    s_lshl_b32 s35, s34, 6
    s_or_b32 s35, s35, s41
    v_lshl_or_b32 v28, v13, 15, s35
    v_and_b32 v29, 48, v4
    v_or_b32 v28, v28, v29
    s_lshl_b32 s34, s34, 4
    s_add_u32 s34, s34, s41
    v_mov_b32 v29, s34
    global_load_dwordx4 v[52:55], v28, s[20:21] offset:2048 sc1
    global_load_dwordx4 v[56:59], v29, s[20:21] offset:3072 sc1
    s_waitcnt vmcnt(0)
    global_store_dwordx4 v28, v[52:55], s[20:21]
    s_waitcnt vmcnt(0)
    global_store_dwordx4 v29, v[56:59], s[20:21] offset:1024
L_hl:
    global_load_dwordx2 v[16:17], v18, s[20:21] offset:1024 sc1
    s_waitcnt vmcnt(0)
    s_branch L_hc
L_hto:
    s_mov_b32 s39, 64
    s_branch L_hok
.section .rodata,"a"
.p2align 6
.amdhsa_kernel standalone__tree_speculative_verify_tree_attention_over_candidate_token_tree__decode_kernel
  .amdhsa_next_free_vgpr 240
  .amdhsa_next_free_sgpr 48
  .amdhsa_accum_offset 240
  .amdhsa_group_segment_fixed_size 0
  .amdhsa_kernarg_size 72
  .amdhsa_user_sgpr_count 2
  .amdhsa_user_sgpr_kernarg_segment_ptr 1
  .amdhsa_system_sgpr_workgroup_id_x 1
.end_amdhsa_kernel
```
